```python
import torch

def _softmax(x, axis=-1):
    return torch.softmax(x, dim=axis)
def _gelu(x):
    return torch.nn.functional.gelu(x, approximate="tanh")
def _silu(x):
    return torch.nn.functional.silu(x)
def _sigmoid(x):
    return torch.sigmoid(x)
def _layernorm(x, axis=-1, eps=1e-5):
    m = x.mean(dim=axis, keepdim=True)
    v = x.var(dim=axis, keepdim=True, unbiased=False)
    return (x - m) / torch.sqrt(v + eps)
def _scatter_add(tgt, idx, src, axis=0):
    return tgt.clone().index_add_(axis, idx, src)
def _segment_sum(src, seg, n):
    out = torch.zeros((n,) + src.shape[1:], dtype=src.dtype)
    return out.index_add_(0, seg, src)
def _pad(x, pw):
    flat = tuple(v for pair in reversed(pw) for v in pair)
    return torch.nn.functional.pad(x, flat)

kernel_name = 'standalone__deepnorm__sampling'

def setup_inputs():

    _w = (lambda a: (lambda t: t.to(torch.bfloat16) if t.is_floating_point() else t)(torch.as_tensor(a)))
    B, S, D = 1024, 8, 1024
    return {
        "x": _w((lambda *s: torch.randn(*s, dtype=torch.bfloat16) * 0.05)(B, S, D)),
        "f": _w((lambda *s: torch.randn(*s, dtype=torch.bfloat16) * 0.05)(B, S, D)),
        "g": _w((lambda *s: torch.randn(*s, dtype=torch.bfloat16) * 0.05)(D) + 1.0),
        "b": _w((lambda *s: torch.randn(*s, dtype=torch.bfloat16) * 0.4)(D)),
        "alpha": _w(float(2.0)),
    }

def reference(x, f, g, b, alpha):
    return _layernorm(alpha * x + f, axis=-1) * g + b
```

```asm
; @launch grid=(512,1,1) block=(512,1,1) lds=0
.amdgcn_target "amdgcn-amd-amdhsa--gfx950"
.text
.globl standalone__deepnorm__sampling_kernel
.p2align 8
.type standalone__deepnorm__sampling_kernel,@function
standalone__deepnorm__sampling_kernel:
    s_load_dwordx8 s[4:11], s[0:1], 0
    s_load_dwordx4 s[12:15], s[0:1], 32
    s_cmp_ge_u32 s2, 512
    s_cbranch_scc1 L_end
    s_cmp_ge_u32 s2, 16
    s_cbranch_scc1 L_nopref
    s_getpc_b64 s[24:25]
L_pc:
    v_and_b32 v3, 63, v0
    v_lshlrev_b32 v3, 6, v3
    v_min_u32 v3, L_end-L_pc, v3
    global_load_dword v7, v3, s[24:25]
L_nopref:
    s_lshl_b32 s3, s2, 14
    v_and_b32 v2, 63, v0
    v_lshrrev_b32 v3, 6, v0
    v_lshlrev_b32 v2, 4, v2
    v_lshl_add_u32 v1, v3, 11, v2
    v_add_u32 v1, s3, v1
    s_mov_b32 s20, 0xffff0000
    s_mov_b32 s21, 0x3f803f80
    s_setprio 1
    s_waitcnt lgkmcnt(0)
    global_load_dwordx4 v[8:11], v1, s[4:5] offset:0 nt
    global_load_dwordx4 v[16:19], v1, s[6:7] offset:0 nt
    global_load_dwordx4 v[12:15], v1, s[4:5] offset:1024 nt
    global_load_dwordx4 v[20:23], v1, s[6:7] offset:1024 nt
    s_load_dword s16, s[12:13], 0
    global_load_dwordx4 v[80:83], v2, s[8:9] offset:0
    global_load_dwordx4 v[88:91], v2, s[10:11] offset:0
    global_load_dwordx4 v[84:87], v2, s[8:9] offset:1024
    global_load_dwordx4 v[92:95], v2, s[10:11] offset:1024
    s_setprio 0
    v_add_u32 v5, 0x800000, v1
    s_waitcnt lgkmcnt(0)
    s_lshl_b32 s17, s16, 16
    s_and_b32 s16, s16, 0xffff
    s_cmp_eq_u32 s2, -1
.p2align 5
L_row:
    v_mov_b32 v40, 0
    v_mov_b32 v42, 0
    s_waitcnt vmcnt(6)
    s_cbranch_scc0 L_w0
    s_waitcnt vmcnt(3)
L_w0:
    v_lshlrev_b32 v24, 16, v16
    v_and_b32 v25, s20, v16
    v_lshlrev_b32 v26, 16, v17
    v_and_b32 v27, s20, v17
    v_lshlrev_b32 v28, 16, v18
    v_and_b32 v29, s20, v18
    v_lshlrev_b32 v30, 16, v19
    v_and_b32 v31, s20, v19
    v_dot2c_f32_bf16 v24, s16, v8
    v_dot2c_f32_bf16 v25, s17, v8
    v_dot2c_f32_bf16 v26, s16, v9
    v_dot2c_f32_bf16 v27, s17, v9
    v_dot2c_f32_bf16 v28, s16, v10
    v_dot2c_f32_bf16 v29, s17, v10
    v_dot2c_f32_bf16 v30, s16, v11
    v_dot2c_f32_bf16 v31, s17, v11
    v_cvt_pk_bf16_f32 v96, v24, v25
    v_cvt_pk_bf16_f32 v97, v26, v27
    v_cvt_pk_bf16_f32 v98, v28, v29
    v_cvt_pk_bf16_f32 v99, v30, v31
    v_dot2c_f32_bf16 v40, s21, v96
    v_dot2c_f32_bf16 v42, v96, v96
    v_dot2c_f32_bf16 v40, s21, v97
    v_dot2c_f32_bf16 v42, v97, v97
    v_dot2c_f32_bf16 v40, s21, v98
    v_dot2c_f32_bf16 v42, v98, v98
    v_dot2c_f32_bf16 v40, s21, v99
    v_dot2c_f32_bf16 v42, v99, v99
    s_waitcnt vmcnt(4)
    s_cbranch_scc0 L_w1
    s_waitcnt vmcnt(1)
L_w1:
    v_lshlrev_b32 v32, 16, v20
    v_and_b32 v33, s20, v20
    v_lshlrev_b32 v34, 16, v21
    v_and_b32 v35, s20, v21
    v_lshlrev_b32 v36, 16, v22
    v_and_b32 v37, s20, v22
    v_lshlrev_b32 v38, 16, v23
    v_and_b32 v39, s20, v23
    v_dot2c_f32_bf16 v32, s16, v12
    v_dot2c_f32_bf16 v33, s17, v12
    v_dot2c_f32_bf16 v34, s16, v13
    v_dot2c_f32_bf16 v35, s17, v13
    v_dot2c_f32_bf16 v36, s16, v14
    v_dot2c_f32_bf16 v37, s17, v14
    v_dot2c_f32_bf16 v38, s16, v15
    v_dot2c_f32_bf16 v39, s17, v15
    s_nop 0
    v_cvt_pk_bf16_f32 v100, v32, v33
    v_cvt_pk_bf16_f32 v101, v34, v35
    v_cvt_pk_bf16_f32 v102, v36, v37
    v_cvt_pk_bf16_f32 v103, v38, v39
    v_dot2c_f32_bf16 v40, s21, v100
    v_dot2c_f32_bf16 v42, v100, v100
    v_dot2c_f32_bf16 v40, s21, v101
    v_dot2c_f32_bf16 v42, v101, v101
    v_dot2c_f32_bf16 v40, s21, v102
    v_dot2c_f32_bf16 v42, v102, v102
    v_dot2c_f32_bf16 v40, s21, v103
    v_dot2c_f32_bf16 v42, v103, v103
    v_lshlrev_b32 v24, 16, v96
    v_and_b32 v25, s20, v96
    v_lshlrev_b32 v26, 16, v97
    v_permlane32_swap_b32 v40, v42
    v_add_f32 v40, v40, v42
    v_and_b32 v27, s20, v97
    v_lshlrev_b32 v28, 16, v98
    v_add_f32_dpp v40, v40, v40 row_ror:8 row_mask:0xf bank_mask:0xf
    v_and_b32 v29, s20, v98
    v_lshlrev_b32 v30, 16, v99
    v_add_f32_dpp v40, v40, v40 row_ror:4 row_mask:0xf bank_mask:0xf
    v_and_b32 v31, s20, v99
    v_lshlrev_b32 v32, 16, v100
    v_add_f32_dpp v40, v40, v40 row_ror:2 row_mask:0xf bank_mask:0xf
    v_and_b32 v33, s20, v100
    v_lshlrev_b32 v34, 16, v101
    v_add_f32_dpp v40, v40, v40 row_ror:1 row_mask:0xf bank_mask:0xf
    v_and_b32 v35, s20, v101
    v_lshlrev_b32 v36, 16, v102
    v_add_f32_dpp v40, v40, v40 row_bcast:15 row_mask:0xa bank_mask:0xf
    v_mul_f32 v40, 0x3a800000, v40
    v_and_b32 v37, s20, v102
    v_readlane_b32 s18, v40, 31
    v_readlane_b32 s19, v40, 63
    v_lshlrev_b32 v38, 16, v103
    v_and_b32 v39, s20, v103
    v_mul_f32 v44, s18, s18
    v_sub_f32 v44, s19, v44
    v_max_f32 v44, 0, v44
    v_cvt_pk_bf16_f32 v45, s18, v44
    v_and_b32 v44, s20, v45
    v_lshlrev_b32 v46, 16, v45
    v_add_f32 v44, 0x3727c5ac, v44
    v_cvt_pk_bf16_f32 v44, v44, v44
    v_lshlrev_b32 v44, 16, v44
    v_sqrt_f32 v44, v44
    s_nop 0
    v_cvt_pk_bf16_f32 v44, v44, v44
    v_lshlrev_b32 v44, 16, v44
    v_rcp_f32 v44, v44
    s_cbranch_scc1 L_gb
    s_waitcnt vmcnt(0)
    v_lshlrev_b32 v48, 16, v80
    v_and_b32 v49, s20, v80
    v_lshlrev_b32 v50, 16, v81
    v_and_b32 v51, s20, v81
    v_lshlrev_b32 v52, 16, v82
    v_and_b32 v53, s20, v82
    v_lshlrev_b32 v54, 16, v83
    v_and_b32 v55, s20, v83
    v_lshlrev_b32 v56, 16, v84
    v_and_b32 v57, s20, v84
    v_lshlrev_b32 v58, 16, v85
    v_and_b32 v59, s20, v85
    v_lshlrev_b32 v60, 16, v86
    v_and_b32 v61, s20, v86
    v_lshlrev_b32 v62, 16, v87
    v_and_b32 v63, s20, v87
    v_lshlrev_b32 v64, 16, v88
    v_and_b32 v65, s20, v88
    v_lshlrev_b32 v66, 16, v89
    v_and_b32 v67, s20, v89
    v_lshlrev_b32 v68, 16, v90
    v_and_b32 v69, s20, v90
    v_lshlrev_b32 v70, 16, v91
    v_and_b32 v71, s20, v91
    v_lshlrev_b32 v72, 16, v92
    v_and_b32 v73, s20, v92
    v_lshlrev_b32 v74, 16, v93
    v_and_b32 v75, s20, v93
    v_lshlrev_b32 v76, 16, v94
    v_and_b32 v77, s20, v94
    v_lshlrev_b32 v78, 16, v95
    v_and_b32 v79, s20, v95
L_gb:
    s_setprio 2
    v_mul_f32 v46, -v46, v44
    v_pk_fma_f32 v[24:25], v[24:25], v[44:45], v[46:47] op_sel_hi:[1,0,0]
    v_pk_fma_f32 v[24:25], v[24:25], v[48:49], v[64:65]
    v_cvt_pk_bf16_f32 v80, v24, v25
    v_pk_fma_f32 v[26:27], v[26:27], v[44:45], v[46:47] op_sel_hi:[1,0,0]
    v_pk_fma_f32 v[26:27], v[26:27], v[50:51], v[66:67]
    v_cvt_pk_bf16_f32 v81, v26, v27
    v_pk_fma_f32 v[28:29], v[28:29], v[44:45], v[46:47] op_sel_hi:[1,0,0]
    v_pk_fma_f32 v[28:29], v[28:29], v[52:53], v[68:69]
    v_cvt_pk_bf16_f32 v82, v28, v29
    v_pk_fma_f32 v[30:31], v[30:31], v[44:45], v[46:47] op_sel_hi:[1,0,0]
    v_pk_fma_f32 v[30:31], v[30:31], v[54:55], v[70:71]
    v_cvt_pk_bf16_f32 v83, v30, v31
    global_store_dwordx4 v1, v[80:83], s[14:15] offset:0 sc1
    s_cbranch_scc1 L_noload
    s_setprio 0
    global_load_dwordx4 v[8:11], v5, s[4:5] offset:0 nt
    global_load_dwordx4 v[16:19], v5, s[6:7] offset:0 nt
    global_load_dwordx4 v[12:15], v5, s[4:5] offset:1024 nt
    global_load_dwordx4 v[20:23], v5, s[6:7] offset:1024 nt
    s_setprio 2
L_noload:
    v_pk_fma_f32 v[32:33], v[32:33], v[44:45], v[46:47] op_sel_hi:[1,0,0]
    v_pk_fma_f32 v[32:33], v[32:33], v[56:57], v[72:73]
    v_cvt_pk_bf16_f32 v84, v32, v33
    v_pk_fma_f32 v[34:35], v[34:35], v[44:45], v[46:47] op_sel_hi:[1,0,0]
    v_pk_fma_f32 v[34:35], v[34:35], v[58:59], v[74:75]
    v_cvt_pk_bf16_f32 v85, v34, v35
    v_pk_fma_f32 v[36:37], v[36:37], v[44:45], v[46:47] op_sel_hi:[1,0,0]
    v_pk_fma_f32 v[36:37], v[36:37], v[60:61], v[76:77]
    v_cvt_pk_bf16_f32 v86, v36, v37
    v_pk_fma_f32 v[38:39], v[38:39], v[44:45], v[46:47] op_sel_hi:[1,0,0]
    v_pk_fma_f32 v[38:39], v[38:39], v[62:63], v[78:79]
    v_cvt_pk_bf16_f32 v87, v38, v39
    global_store_dwordx4 v1, v[84:87], s[14:15] offset:1024 sc1
    s_setprio 0
    s_cbranch_scc1 L_done
    v_mov_b32 v1, v5
    s_cmp_eq_u32 s2, s2
    s_branch L_row
L_done:
L_end:
    s_endpgm
.section .rodata,"a"
.p2align 6
.amdhsa_kernel standalone__deepnorm__sampling_kernel
.amdhsa_next_free_vgpr 104
.amdhsa_next_free_sgpr 32
.amdhsa_accum_offset 104
.amdhsa_group_segment_fixed_size 0
.amdhsa_kernarg_size 64
.amdhsa_user_sgpr_count 2
.amdhsa_user_sgpr_kernarg_segment_ptr 1
.amdhsa_system_sgpr_workgroup_id_x 1
.amdhsa_float_denorm_mode_32 3
.end_amdhsa_kernel
```
